```python
import torch

def _softmax(x, axis=-1):
    return torch.softmax(x, dim=axis)
def _gelu(x):
    return torch.nn.functional.gelu(x, approximate="tanh")
def _silu(x):
    return torch.nn.functional.silu(x)
def _sigmoid(x):
    return torch.sigmoid(x)
def _layernorm(x, axis=-1, eps=1e-5):
    m = x.mean(dim=axis, keepdim=True)
    v = x.var(dim=axis, keepdim=True, unbiased=False)
    return (x - m) / torch.sqrt(v + eps)
def _scatter_add(tgt, idx, src, axis=0):
    return tgt.clone().index_add_(axis, idx, src)
def _segment_sum(src, seg, n):
    out = torch.zeros((n,) + src.shape[1:], dtype=src.dtype)
    return out.index_add_(0, seg, src)
def _pad(x, pw):
    flat = tuple(v for pair in reversed(pw) for v in pair)
    return torch.nn.functional.pad(x, flat)

kernel_name = 'standalone__edge_featured_mpnn_gatedgcn__graph'

def setup_inputs():

    _w = (lambda a: (lambda t: t.to(torch.bfloat16) if t.is_floating_point() else t)(torch.as_tensor(a)))
    N, deg, D, De = 10000, 64, 64, max(0, 1)
    E = N * deg
    return {
        "x": _w((lambda *s: torch.randn(*s, dtype=torch.bfloat16) * 0.8)(N, D)),
        "e_attr": _w((lambda *s: torch.randn(*s, dtype=torch.bfloat16) * 1.6)(E, De)),
        "src": _w((lambda lo, hi, *s: torch.randint(lo, hi, s))(0, N, E).to(torch.int64)),
        "dst": _w((lambda lo, hi, *s: torch.randint(lo, hi, s))(0, N, E).to(torch.int64)),
        "w_a": _w((lambda *s: torch.randn(*s, dtype=torch.bfloat16) * 0.8)(D, D)),
        "w_b": _w((lambda *s: torch.randn(*s, dtype=torch.bfloat16) * 0.8)(D, D)),
        "w_c": _w((lambda *s: torch.randn(*s, dtype=torch.bfloat16) * 1.6)(De, D)),
        "w_u": _w((lambda *s: torch.randn(*s, dtype=torch.bfloat16) * 0.05)(D, D)),
        "w_v": _w((lambda *s: torch.randn(*s, dtype=torch.bfloat16) * 0.05)(D, D)),
    }

def reference(x, e_attr, src, dst, w_a, w_b, w_c, w_u, w_v):
    N, D = x.shape
    hv = x @ w_v
    g = x[dst] @ w_a + x[src] @ w_b + e_attr @ w_c
    eta = _sigmoid(g)
    denom = _segment_sum(eta, dst, N) + 1e-6
    eta_n = eta / denom[dst]
    agg = _segment_sum(eta_n * hv[src], dst, N)
    z = x @ w_u + agg
    relu_z = torch.where(z > 0, z, 0 * z)
    return x + relu_z
```

```asm
; @launch grid=(256,1,1) block=(1024,1,1) lds=120576
.amdgcn_target "amdgcn-amd-amdhsa--gfx950"
.text
.globl standalone__edge_featured_mpnn_gatedgcn__graph_kernel
.p2align 8
.type standalone__edge_featured_mpnn_gatedgcn__graph_kernel,@function
standalone__edge_featured_mpnn_gatedgcn__graph_kernel:
    s_cmp_ge_u32 s2, 256
    s_cbranch_scc1 K_done
    s_load_dwordx8 s[4:11], s[0:1], 0
    s_load_dwordx2 s[24:25], s[0:1], 88
    s_load_dwordx8 s[12:19], s[0:1], 32
    s_load_dwordx4 s[20:23], s[0:1], 64
    v_and_b32 v1, 63, v0
    v_lshrrev_b32 v2, 6, v0
    v_lshlrev_b32 v3, 4, v0
    v_readfirstlane_b32 s3, v2
    v_lshlrev_b32 v4, 2, v1
    v_mov_b32 v60, 1
    v_mov_b32 v61, 0
    v_mov_b32 v62, 0
    v_lshlrev_b32 v63, 2, v0
    v_lshlrev_b32 v8, 3, v0
    v_cmp_gt_u32 vcc, 625, v0
    s_mul_i32 s90, s2, 10000
    s_mul_i32 s91, s2, 5000
    s_mov_b64 s[72:73], vcc
    s_cmp_ge_u32 s3, 7
    s_cbranch_scc1 K_nozero
    ds_write_b32 v63, v62
K_nozero:
    v_and_b32 v5, 15, v1
    v_lshrrev_b32 v2, 4, v1
    s_cmp_ge_u32 s3, 10
    s_cbranch_scc1 K_tab_start
    s_waitcnt lgkmcnt(0)
    s_mov_b32 s28, s10
    s_and_b32 s29, s11, 0xffff
    s_mov_b32 s30, 0x271000
    s_mov_b32 s31, 0x20000
    s_mov_b64 exec, s[72:73]
    buffer_load_dwordx4 v[32:35], v3, s[28:31], s90 offen
    s_mov_b64 exec, -1
    s_mov_b32 s32, s8
    s_and_b32 s33, s9, 0xffff
    s_mov_b32 s34, 0x271000
    s_mov_b32 s35, 0x20000
    s_mov_b32 s36, s6
    s_and_b32 s37, s7, 0xffff
    s_mov_b32 s38, 0x138800
    s_mov_b32 s39, 0x20000
    s_add_u32 s60, s24, 0x7f0000
    s_addc_u32 s61, s25, 0
    s_and_b32 s61, s61, 0xffff
    s_mov_b32 s62, 0x8
    s_mov_b32 s63, 0x20000
    s_barrier
    s_mov_b64 exec, s[72:73]
    buffer_load_dwordx4 v[36:39], v3, s[32:35], s90 offen
    buffer_load_dwordx2 v[40:41], v8, s[36:39], s91 offen
    s_mov_b64 exec, -1
    buffer_load_dwordx2 v[10:11], v61, s[60:63], 0 offen
    v_mov_b32 v48, 2560000
    v_mov_b32 v49, 2560000
    v_mov_b32 v50, 2560000
    v_mov_b32 v51, 2560000
    v_mov_b32 v52, 0
    v_mov_b32 v53, 0
    v_mov_b32 v54, 0
    v_mov_b32 v55, 0
    s_cmp_ge_u32 s3, 13
    s_cbranch_scc1 K_nofilla
    v_cmp_gt_u32 vcc, 800, v0
    s_and_saveexec_b64 s[88:89], vcc
    ds_write_b128 v3, v[48:51] offset:2816
    ds_write_b128 v3, v[52:55] offset:15616
    s_mov_b64 exec, s[88:89]
K_nofilla:
    v_lshlrev_b32 v56, 4, v1
    v_add_u32 v56, 120064, v56
    s_cmp_lg_u32 s3, 0
    s_cbranch_scc1 K_nozs
    s_mov_b32 exec_hi, 0
    ds_write_b128 v56, v[52:55]
    s_mov_b64 exec, -1
K_nozs:

    s_and_b32 s71, s2, 7
    s_lshl_b32 s71, s71, 5
    s_lshr_b32 s67, s2, 3
    s_or_b32 s71, s71, s67
    s_mul_i32 s64, s71, 40000
    s_lshr_b32 s64, s64, 10
1:
    s_mul_i32 s67, s64, 26843
    s_lshr_b32 s67, s67, 20
    s_cmp_ge_u32 s67, s71
    s_cbranch_scc1 2f
    s_add_u32 s64, s64, 1
    s_branch 1b
2:
    s_add_u32 s68, s71, 1
    s_mul_i32 s65, s68, 40000
    s_lshr_b32 s65, s65, 10
3:
    s_mul_i32 s67, s65, 26843
    s_lshr_b32 s67, s67, 20
    s_cmp_ge_u32 s67, s68
    s_cbranch_scc1 4f
    s_add_u32 s65, s65, 1
    s_branch 3b
4:
    s_min_u32 s65, s65, 10000
    s_sub_u32 s65, s65, s64
    s_lshl_b32 s66, s64, 2
    v_add_u32 v6, 16, v5
    v_lshrrev_b32 v62, 4, v0
    v_mul_u32_u24 v7, 80000, v62
    v_lshlrev_b32 v69, 1, v1
    s_mov_b32 s40, s4
    s_and_b32 s41, s5, 0xffff
    s_mov_b32 s42, 0x138800
    s_mov_b32 s43, 0x20000
    s_mov_b32 s36, s16
    s_and_b32 s37, s17, 0xffff
    s_mov_b32 s38, 0x80
    s_mov_b32 s39, 0x20000
    s_add_u32 s44, s24, 0x280000
    s_addc_u32 s45, s25, 0
    s_and_b32 s45, s45, 0xffff
    s_mov_b32 s46, 0x80000
    s_mov_b32 s47, 0x20000
    s_add_u32 s48, s24, 0x300000
    s_addc_u32 s49, s25, 0
    s_and_b32 s49, s49, 0xffff
    s_mov_b32 s50, 0x4e2000
    s_mov_b32 s51, 0x20000
    s_mov_b32 s52, s24
    s_and_b32 s53, s25, 0xffff
    s_or_b32 s53, s53, 0x40000
    s_mov_b32 s54, 0x271100
    s_mov_b32 s55, 0x800000
    s_mov_b32 s56, s24
    s_and_b32 s57, s25, 0xffff
    s_mov_b32 s58, 0x271100
    s_mov_b32 s59, 0x20000
    s_mov_b32 s60, s22
    s_and_b32 s61, s23, 0xffff
    s_mov_b32 s62, 0x138800
    s_mov_b32 s63, 0x20000
    v_add_u32 v68, s64, v62
    v_lshlrev_b32 v68, 7, v68
    v_lshl_add_u32 v68, v5, 3, v68
    s_mov_b64 exec, s[72:73]
    s_waitcnt vmcnt(3)
    v_mul_u32_u24 v44, 26843, v32
    v_mul_u32_u24 v45, 26843, v33
    v_mul_u32_u24 v46, 26843, v34
    v_mul_u32_u24 v47, 26843, v35
    v_lshrrev_b32 v44, 18, v44
    v_lshrrev_b32 v45, 18, v45
    v_lshrrev_b32 v46, 18, v46
    v_lshrrev_b32 v47, 18, v47
    v_and_b32 v44, 0x3fc, v44
    v_and_b32 v45, 0x3fc, v45
    v_and_b32 v46, 0x3fc, v46
    v_and_b32 v47, 0x3fc, v47
    ds_add_rtn_u32 v48, v44, v60 offset:768
    ds_add_rtn_u32 v49, v45, v60 offset:768
    ds_add_rtn_u32 v50, v46, v60 offset:768
    ds_add_rtn_u32 v51, v47, v60 offset:768
    v_and_b32 v32, 63, v32
    v_and_b32 v33, 63, v33
    v_and_b32 v34, 63, v34
    v_and_b32 v35, 63, v35
    s_mov_b64 exec, -1
    s_waitcnt lgkmcnt(0)
    s_barrier
    s_cmp_lg_u32 s3, 0
    s_cbranch_scc1 K_noscan
    ds_read_b128 v[72:75], v3 offset:768
    s_waitcnt lgkmcnt(0)
    v_add_u32 v76, v72, v73
    v_add_u32 v77, v76, v74
    v_add_u32 v78, v77, v75
    v_mov_b32 v79, v78
    s_nop 1
    v_add_u32_dpp v79, v79, v79 row_shr:1 row_mask:0xf bank_mask:0xf bound_ctrl:1
    s_nop 1
    v_add_u32_dpp v79, v79, v79 row_shr:2 row_mask:0xf bank_mask:0xf bound_ctrl:1
    s_nop 1
    v_add_u32_dpp v79, v79, v79 row_shr:4 row_mask:0xf bank_mask:0xf bound_ctrl:1
    s_nop 1
    v_add_u32_dpp v79, v79, v79 row_shr:8 row_mask:0xf bank_mask:0xf bound_ctrl:1
    s_nop 1
    v_add_u32_dpp v79, v79, v79 row_bcast:15 row_mask:0xa bank_mask:0xf
    s_nop 1
    v_add_u32_dpp v79, v79, v79 row_bcast:31 row_mask:0xc bank_mask:0xf
    v_sub_u32 v80, v79, v78
    v_add_u32 v81, v80, v72
    v_add_u32 v82, v80, v76
    v_add_u32 v83, v80, v77
    ds_write_b128 v3, v[80:83] offset:1792
K_noscan:
    s_waitcnt lgkmcnt(0)
    s_barrier
    s_mov_b64 exec, s[72:73]
    ds_read_b32 v12, v44 offset:1792
    ds_read_b32 v13, v45 offset:1792
    ds_read_b32 v14, v46 offset:1792
    ds_read_b32 v15, v47 offset:1792
    s_waitcnt vmcnt(0)
    v_lshl_or_b32 v52, v36, 8, v32
    v_lshl_or_b32 v54, v37, 8, v33
    v_lshl_or_b32 v56, v38, 8, v34
    v_lshl_or_b32 v58, v39, 8, v35
    v_lshlrev_b32 v53, 16, v40
    v_and_b32 v55, 0xffff0000, v40
    v_lshlrev_b32 v57, 16, v41
    v_and_b32 v59, 0xffff0000, v41
    s_waitcnt lgkmcnt(0)
    v_add_lshl_u32 v40, v12, v48, 3
    v_add_lshl_u32 v41, v13, v49, 3
    v_add_lshl_u32 v42, v14, v50, 3
    v_add_lshl_u32 v43, v15, v51, 3
    ds_write_b64 v40, v[52:53] offset:41472
    ds_write_b64 v41, v[54:55] offset:41472
    ds_write_b64 v42, v[56:57] offset:41472
    ds_write_b64 v43, v[58:59] offset:41472
    s_mov_b64 exec, -1
    v_add_u32 v8, 10240, v3
    v_cmp_gt_u32 vcc, 610, v0
    s_mul_i32 s67, s2, 20000
    s_mov_b64 s[96:97], vcc
    v_readfirstlane_b32 s26, v10
    v_readfirstlane_b32 s27, v11
    s_waitcnt lgkmcnt(0)
    s_barrier
    ds_read_b128 v[32:35], v3 offset:41472
    s_mov_b64 exec, s[96:97]
    ds_read_b128 v[36:39], v8 offset:41472
    s_mov_b64 exec, -1
    s_waitcnt lgkmcnt(0)
    buffer_store_dwordx4 v[32:35], v3, s[48:51], s67 offen sc1
    s_mov_b64 exec, s[96:97]
    buffer_store_dwordx4 v[36:39], v8, s[48:51], s67 offen sc1
    s_mov_b64 exec, -1
    s_add_u32 s26, s26, 1
    s_addc_u32 s27, s27, 0
    s_and_b32 s94, s26, 0xff
    s_lshl_b32 s94, s94, 24
    s_lshr_b64 s[96:97], s[26:27], 8
    s_mov_b32 s95, s96
    v_lshrrev_b32 v8, 4, v0
    v_lshlrev_b32 v86, 15, v8
    v_lshl_add_u32 v86, v5, 3, v86
    v_and_b32 v9, 255, v0
    v_lshlrev_b32 v9, 2, v9
    ds_read_b32 v84, v9 offset:1792
    ds_read_b32 v85, v9 offset:768
    s_waitcnt lgkmcnt(0)
    v_lshl_or_b32 v84, v85, 12, v84
    v_or_b32 v84, s94, v84
    v_mov_b32 v85, s95
    s_lshl_b32 s67, s2, 7
    v_mov_b32 v12, s26
    v_mov_b32 v13, s27
    s_mov_b64 exec, 1
    ds_write_b64 v61, v[12:13] offset:544
    s_mov_b64 exec, -1
    s_waitcnt vmcnt(0) lgkmcnt(0)
    s_barrier
    s_cmp_ge_u32 s3, 4
    s_cbranch_scc1 K_poll_setup
    buffer_store_dwordx2 v[84:85], v86, s[44:47], s67 offen sc1
    s_waitcnt vmcnt(0)
    s_branch K_poll_setup
K_tab_start:
    s_sub_u32 s67, s3, 10
    s_lshr_b32 s69, s67, 1
    s_and_b32 s70, s67, 1
    s_lshl_b32 s67, s69, 4
    s_mul_i32 s68, s2, 40
    s_add_u32 s68, s68, s67
    v_add_u32 v9, s68, v5
    v_lshlrev_b32 v10, 7, v9
    v_lshl_add_u32 v10, v2, 4, v10
    v_subrev_u32 v11, 640, v0
    v_lshlrev_b32 v12, 4, v11
    v_add_u32 v13, 6144, v12
    s_waitcnt lgkmcnt(0)
    s_barrier
    s_mov_b32 s28, s4
    s_and_b32 s29, s5, 0xffff
    s_mov_b32 s30, 0x138800
    s_mov_b32 s31, 0x20000
    s_mov_b32 s32, s14
    s_and_b32 s33, s15, 0xffff
    s_mov_b32 s34, 0x2000
    s_mov_b32 s35, 0x20000
    s_mov_b32 s36, s20
    s_and_b32 s37, s21, 0xffff
    s_mov_b32 s38, 0x2000
    s_mov_b32 s39, 0x20000
    buffer_load_dwordx4 v[32:35], v10, s[28:31], 0 offen
    buffer_load_dwordx4 v[36:39], v10, s[28:31], 0 offen offset:64
    buffer_load_dwordx4 v[72:75], v12, s[32:35], 0 offen
    buffer_load_dwordx4 v[76:79], v12, s[36:39], 0 offen
    s_cmp_ge_u32 s3, 12
    s_cbranch_scc1 K_tab_ld1
    buffer_load_dwordx4 v[80:83], v13, s[32:35], 0 offen
    buffer_load_dwordx4 v[84:87], v13, s[36:39], 0 offen
K_tab_ld1:
    v_mov_b32 v48, 2560000
    v_mov_b32 v49, 2560000
    v_mov_b32 v50, 2560000
    v_mov_b32 v51, 2560000
    v_mov_b32 v52, 0
    v_mov_b32 v53, 0
    v_mov_b32 v54, 0
    v_mov_b32 v55, 0
    s_cmp_ge_u32 s3, 13
    s_cbranch_scc1 K_nofillb
    v_cmp_gt_u32 vcc, 800, v0
    s_and_saveexec_b64 s[88:89], vcc
    ds_write_b128 v3, v[48:51] offset:2816
    ds_write_b128 v3, v[52:55] offset:15616
    s_mov_b64 exec, s[88:89]
K_nofillb:
    v_mov_b32 v16, v12
    v_mov_b32 v17, v13
    s_and_b32 s71, s2, 7
    s_lshl_b32 s71, s71, 5
    s_lshr_b32 s67, s2, 3
    s_or_b32 s71, s71, s67
    s_mul_i32 s64, s71, 40000
    s_lshr_b32 s64, s64, 10
1:
    s_mul_i32 s67, s64, 26843
    s_lshr_b32 s67, s67, 20
    s_cmp_ge_u32 s67, s71
    s_cbranch_scc1 2f
    s_add_u32 s64, s64, 1
    s_branch 1b
2:
    s_add_u32 s68, s71, 1
    s_mul_i32 s65, s68, 40000
    s_lshr_b32 s65, s65, 10
3:
    s_mul_i32 s67, s65, 26843
    s_lshr_b32 s67, s67, 20
    s_cmp_ge_u32 s67, s68
    s_cbranch_scc1 4f
    s_add_u32 s65, s65, 1
    s_branch 3b
4:
    s_min_u32 s65, s65, 10000
    s_sub_u32 s65, s65, s64
    s_lshl_b32 s66, s64, 2
    v_add_u32 v6, 16, v5
    v_lshrrev_b32 v62, 4, v0
    v_mul_u32_u24 v7, 80000, v62
    v_lshlrev_b32 v69, 1, v1
    s_mov_b32 s40, s4
    s_and_b32 s41, s5, 0xffff
    s_mov_b32 s42, 0x138800
    s_mov_b32 s43, 0x20000
    s_mov_b32 s36, s16
    s_and_b32 s37, s17, 0xffff
    s_mov_b32 s38, 0x80
    s_mov_b32 s39, 0x20000
    s_add_u32 s44, s24, 0x280000
    s_addc_u32 s45, s25, 0
    s_and_b32 s45, s45, 0xffff
    s_mov_b32 s46, 0x80000
    s_mov_b32 s47, 0x20000
    s_add_u32 s48, s24, 0x300000
    s_addc_u32 s49, s25, 0
    s_and_b32 s49, s49, 0xffff
    s_mov_b32 s50, 0x4e2000
    s_mov_b32 s51, 0x20000
    s_mov_b32 s52, s24
    s_and_b32 s53, s25, 0xffff
    s_or_b32 s53, s53, 0x40000
    s_mov_b32 s54, 0x271100
    s_mov_b32 s55, 0x800000
    s_mov_b32 s56, s24
    s_and_b32 s57, s25, 0xffff
    s_mov_b32 s58, 0x271100
    s_mov_b32 s59, 0x20000
    s_mov_b32 s60, s22
    s_and_b32 s61, s23, 0xffff
    s_mov_b32 s62, 0x138800
    s_mov_b32 s63, 0x20000
    v_lshrrev_b32 v14, 3, v11
    v_mul_u32_u24 v14, 144, v14
    v_and_b32 v15, 7, v11
    v_lshl_add_u32 v14, v15, 4, v14
    v_add_u32 v14, 83200, v14
    v_add_u32 v15, 6912, v14
    v_bfe_u32 v67, v1, 2, 2
    v_lshl_add_u32 v67, v2, 3, v67
    v_mul_u32_u24 v67, 144, v67
    v_and_b32 v63, 3, v1
    v_lshl_add_u32 v67, v63, 3, v67
    s_lshl_b32 s67, s70, 6
    s_add_u32 s67, s67, 83200
    v_add_u32 v67, s67, v67
    s_sub_u32 s67, s3, 10
    s_mov_b32 s68, 63232
    s_cmp_ge_u32 s67, 3
    s_cselect_b32 s68, s68, 28416
    s_mul_i32 s67, s67, 2304
    s_add_u32 s67, s67, s68
    v_mul_u32_u24 v10, 144, v5
    v_lshl_add_u32 v10, v2, 4, v10
    v_add_u32 v10, s67, v10
    v_lshrrev_b32 v11, 3, v1
    v_mul_u32_u24 v12, 144, v11
    v_and_b32 v13, 7, v1
    v_lshl_add_u32 v12, v13, 4, v12
    v_add_u32 v12, s67, v12
    s_lshl_b32 s67, s69, 4
    v_add_u32 v11, s67, v11
    v_lshlrev_b32 v9, 8, v11
    v_lshl_add_u32 v9, v13, 4, v9
    v_mov_b32 v8, 0
    s_waitcnt lgkmcnt(0)
    s_barrier
    s_barrier
    s_mov_b32 s28, s12
    s_and_b32 s29, s13, 0xffff
    s_mov_b32 s30, 0x2000
    s_mov_b32 s31, 0x20000
    s_mov_b32 s32, s18
    s_and_b32 s33, s19, 0xffff
    s_mov_b32 s34, 0x2000
    s_mov_b32 s35, 0x20000
    buffer_load_dwordx4 v[120:123], v16, s[28:31], 0 offen
    buffer_load_dwordx4 v[52:55], v16, s[32:35], 0 offen
    s_cmp_ge_u32 s3, 12
    s_cbranch_scc1 K_tab_ld2
    buffer_load_dwordx4 v[56:59], v17, s[28:31], 0 offen
    buffer_load_dwordx4 v[28:31], v17, s[32:35], 0 offen
K_tab_ld2:
    s_lshl_b32 s67, s69, 4
    s_add_u32 s67, s67, s64
    v_add_u32 v62, s67, v5
    v_lshlrev_b32 v62, 7, v62
    v_lshl_add_u32 v62, v2, 4, v62
    buffer_load_dwordx4 v[16:19], v62, s[40:43], 0 offen
    buffer_load_dwordx4 v[20:23], v62, s[40:43], 0 offen offset:64
    s_barrier
    s_cmp_ge_u32 s3, 12
    s_cbranch_scc1 K_tab_w5
    s_waitcnt vmcnt(6)
    s_branch K_tab_w
K_tab_w5:
    s_waitcnt vmcnt(4)
K_tab_w:
    ds_write_b128 v14, v[72:75] offset:18432
    ds_write_b128 v14, v[76:79] offset:27648
    s_cmp_ge_u32 s3, 12
    s_cbranch_scc1 K_tab_st0
    ds_write_b128 v15, v[80:83] offset:18432
    ds_write_b128 v15, v[84:87] offset:27648
K_tab_st0:
    s_waitcnt lgkmcnt(0)
    s_mov_b64 exec, 1
    ds_add_u32 v8, v60 offset:516
    s_mov_b64 exec, -1
    s_mov_b32 s98, 0
K_tab_meet:
    ds_read_b32 v62, v8 offset:516
    s_add_u32 s98, s98, 1
    s_waitcnt lgkmcnt(0)
    v_readfirstlane_b32 s67, v62
    s_cmp_ge_u32 s98, 20000000
    s_cbranch_scc1 K_tab_met
    s_cmp_lt_u32 s67, 6
    s_cbranch_scc1 K_tab_meet
K_tab_met:
    ds_read_b64_tr_b16 v[72:73], v67 offset:18432
    ds_read_b64_tr_b16 v[74:75], v67 offset:19008
    ds_read_b64_tr_b16 v[76:77], v67 offset:23040
    ds_read_b64_tr_b16 v[78:79], v67 offset:23616
    ds_read_b64_tr_b16 v[80:81], v67 offset:18464
    ds_read_b64_tr_b16 v[82:83], v67 offset:19040
    ds_read_b64_tr_b16 v[84:85], v67 offset:23072
    ds_read_b64_tr_b16 v[86:87], v67 offset:23648
    ds_read_b64_tr_b16 v[88:89], v67 offset:27648
    ds_read_b64_tr_b16 v[90:91], v67 offset:28224
    ds_read_b64_tr_b16 v[92:93], v67 offset:32256
    ds_read_b64_tr_b16 v[94:95], v67 offset:32832
    ds_read_b64_tr_b16 v[96:97], v67 offset:27680
    ds_read_b64_tr_b16 v[98:99], v67 offset:28256
    ds_read_b64_tr_b16 v[100:101], v67 offset:32288
    ds_read_b64_tr_b16 v[102:103], v67 offset:32864
    s_waitcnt lgkmcnt(12)
    v_mfma_f32_16x16x32_bf16 v[104:107], v[72:75], v[32:35], 0
    v_mfma_f32_16x16x32_bf16 v[104:107], v[76:79], v[36:39], v[104:107]
    s_waitcnt lgkmcnt(8)
    v_mfma_f32_16x16x32_bf16 v[108:111], v[80:83], v[32:35], 0
    v_mfma_f32_16x16x32_bf16 v[108:111], v[84:87], v[36:39], v[108:111]
    s_waitcnt lgkmcnt(4)
    v_mfma_f32_16x16x32_bf16 v[112:115], v[88:91], v[32:35], 0
    v_mfma_f32_16x16x32_bf16 v[112:115], v[92:95], v[36:39], v[112:115]
    s_waitcnt lgkmcnt(0)
    v_mfma_f32_16x16x32_bf16 v[116:119], v[96:99], v[32:35], 0
    v_mfma_f32_16x16x32_bf16 v[116:119], v[100:103], v[36:39], v[116:119]
    s_mov_b32 s67, 0xbfb8aa3b
    s_mov_b32 s68, 0xffff0000
    s_mov_b32 s98, 0x80000000
    s_mov_b32 s99, 0x7fffffff
    s_lshl_b32 s91, s70, 7
    s_mul_i32 s92, s2, 10240
    s_add_u32 s92, s92, s91
    s_nop 1
    v_mul_f32 v104, s67, v104
    v_mul_f32 v105, s67, v105
    v_mul_f32 v106, s67, v106
    v_mul_f32 v107, s67, v107
    v_cvt_pk_bf16_f32 v40, v104, v105
    v_cvt_pk_bf16_f32 v41, v106, v107
    v_and_b32 v104, 0xffff, v40
    v_lshrrev_b32 v105, 16, v40
    v_and_b32 v106, 0xffff, v41
    v_lshrrev_b32 v107, 16, v41
    v_and_b32 v44, s99, v112
    v_and_b32 v45, s99, v113
    v_and_b32 v46, s99, v114
    v_and_b32 v47, s99, v115
    v_add_u32 v44, 0x8000, v44
    v_add_u32 v45, 0x8000, v45
    v_add_u32 v46, 0x8000, v46
    v_add_u32 v47, 0x8000, v47
    v_sub_u32_e64 v44, v44, v104 clamp
    v_sub_u32_e64 v45, v45, v105 clamp
    v_sub_u32_e64 v46, v46, v106 clamp
    v_sub_u32_e64 v47, v47, v107 clamp
    v_and_or_b32 v44, v44, s68, v104
    v_and_or_b32 v45, v45, s68, v105
    v_and_or_b32 v46, v46, s68, v106
    v_and_or_b32 v47, v47, s68, v107
    v_and_or_b32 v44, v112, s98, v44
    v_and_or_b32 v45, v113, s98, v45
    v_and_or_b32 v46, v114, s98, v46
    v_and_or_b32 v47, v115, s98, v47
    ds_write_b128 v10, v[44:47] offset:0
    v_mul_f32 v108, s67, v108
    v_mul_f32 v109, s67, v109
    v_mul_f32 v110, s67, v110
    v_mul_f32 v111, s67, v111
    v_cvt_pk_bf16_f32 v40, v108, v109
    v_cvt_pk_bf16_f32 v41, v110, v111
    v_and_b32 v108, 0xffff, v40
    v_lshrrev_b32 v109, 16, v40
    v_and_b32 v110, 0xffff, v41
    v_lshrrev_b32 v111, 16, v41
    v_and_b32 v48, s99, v116
    v_and_b32 v49, s99, v117
    v_and_b32 v50, s99, v118
    v_and_b32 v51, s99, v119
    v_add_u32 v48, 0x8000, v48
    v_add_u32 v49, 0x8000, v49
    v_add_u32 v50, 0x8000, v50
    v_add_u32 v51, 0x8000, v51
    v_sub_u32_e64 v48, v48, v108 clamp
    v_sub_u32_e64 v49, v49, v109 clamp
    v_sub_u32_e64 v50, v50, v110 clamp
    v_sub_u32_e64 v51, v51, v111 clamp
    v_and_or_b32 v48, v48, s68, v108
    v_and_or_b32 v49, v49, s68, v109
    v_and_or_b32 v50, v50, s68, v110
    v_and_or_b32 v51, v51, s68, v111
    v_and_or_b32 v48, v116, s98, v48
    v_and_or_b32 v49, v117, s98, v49
    v_and_or_b32 v50, v118, s98, v50
    v_and_or_b32 v51, v119, s98, v51
    ds_write_b128 v10, v[48:51] offset:64
    s_waitcnt lgkmcnt(0)
    ds_read_b128 v[44:47], v12
    ds_read_b128 v[48:51], v12 offset:1152
    v_cmp_gt_u32 vcc, 40, v11
    s_mov_b64 s[72:73], vcc
    v_cmp_gt_u32 vcc, 32, v11
    s_mov_b64 s[74:75], vcc
    s_waitcnt vmcnt(0)
    ds_write_b128 v14, v[120:123]
    ds_write_b128 v14, v[52:55] offset:9216
    s_cmp_ge_u32 s3, 12
    s_cbranch_scc1 K_tab_st2
    ds_write_b128 v15, v[56:59]
    ds_write_b128 v15, v[28:31] offset:9216
K_tab_st2:
    s_waitcnt lgkmcnt(0)
    s_cmp_ge_u32 s2, 250
    s_cbranch_scc1 K_tab_norows
    s_mov_b64 exec, s[72:73]
    s_cbranch_execz K_tab_r1
    buffer_store_dwordx4 v[44:47], v9, s[56:59], s92 offen sc1
K_tab_r1:
    s_mov_b64 exec, s[74:75]
    s_cbranch_execz K_tab_r2
    buffer_store_dwordx4 v[48:51], v9, s[56:59], s92 offen offset:2048 sc1
K_tab_r2:
    s_mov_b64 exec, -1
    s_branch K_tab_stored
K_tab_norows:
    s_cmp_lg_u32 s2, 250
    s_cbranch_scc1 K_tab_stored
    s_cmp_lg_u32 s3, 10
    s_cbranch_scc1 K_tab_stored
    v_mov_b32 v44, 0x7f00
    s_mov_b32 s67, 2560000
    buffer_store_dword v44, v4, s[56:59], s67 offen sc1
K_tab_stored:
    s_barrier
    ds_read_b64 v[124:125], v61 offset:544
    ds_read_b64_tr_b16 v[72:73], v67 offset:0
    ds_read_b64_tr_b16 v[74:75], v67 offset:576
    ds_read_b64_tr_b16 v[76:77], v67 offset:4608
    ds_read_b64_tr_b16 v[78:79], v67 offset:5184
    ds_read_b64_tr_b16 v[80:81], v67 offset:9216
    ds_read_b64_tr_b16 v[82:83], v67 offset:9792
    ds_read_b64_tr_b16 v[84:85], v67 offset:13824
    ds_read_b64_tr_b16 v[86:87], v67 offset:14400
    ds_read_b64_tr_b16 v[88:89], v67 offset:32
    ds_read_b64_tr_b16 v[90:91], v67 offset:608
    ds_read_b64_tr_b16 v[92:93], v67 offset:4640
    ds_read_b64_tr_b16 v[94:95], v67 offset:5216
    ds_read_b64_tr_b16 v[96:97], v67 offset:9248
    ds_read_b64_tr_b16 v[98:99], v67 offset:9824
    ds_read_b64_tr_b16 v[100:101], v67 offset:13856
    ds_read_b64_tr_b16 v[102:103], v67 offset:14432
    s_lshl_b32 s68, s69, 4
    v_add_u32 v9, s68, v5
    v_mul_u32_u24 v9, 272, v9
    v_lshl_add_u32 v9, v2, 4, v9
    s_lshl_b32 s67, s70, 7
    v_add_u32 v9, s67, v9
    v_add_u32 v11, 70144, v9
    s_waitcnt lgkmcnt(12)
    v_mfma_f32_16x16x32_bf16 v[104:107], v[72:75], v[16:19], 0
    v_mfma_f32_16x16x32_bf16 v[104:107], v[76:79], v[20:23], v[104:107]
    s_waitcnt lgkmcnt(8)
    v_mfma_f32_16x16x32_bf16 v[108:111], v[80:83], v[16:19], 0
    v_mfma_f32_16x16x32_bf16 v[108:111], v[84:87], v[20:23], v[108:111]
    s_waitcnt lgkmcnt(4)
    v_mfma_f32_16x16x32_bf16 v[112:115], v[88:91], v[16:19], 0
    v_mfma_f32_16x16x32_bf16 v[112:115], v[92:95], v[20:23], v[112:115]
    s_waitcnt lgkmcnt(0)
    v_mfma_f32_16x16x32_bf16 v[116:119], v[96:99], v[16:19], 0
    v_mfma_f32_16x16x32_bf16 v[116:119], v[100:103], v[20:23], v[116:119]
    s_mov_b32 s67, 0xbfb8aa3b
    v_mov_b32 v10, 0xc27c0000
    s_nop 7
    v_fma_f32 v104, v104, s67, v10
    v_fma_f32 v105, v105, s67, v10
    v_fma_f32 v106, v106, s67, v10
    v_fma_f32 v107, v107, s67, v10
    ds_write_b128 v9, v[104:107] offset:28416
    ds_write_b128 v11, v[108:111] offset:0
    v_fma_f32 v112, v112, s67, v10
    v_fma_f32 v113, v113, s67, v10
    v_fma_f32 v114, v114, s67, v10
    v_fma_f32 v115, v115, s67, v10
    ds_write_b128 v9, v[112:115] offset:28480
    ds_write_b128 v11, v[116:119] offset:64
    v_readfirstlane_b32 s26, v124
    v_readfirstlane_b32 s27, v125
    s_nop 3
    s_and_b32 s94, s26, 0xff
    s_lshl_b32 s94, s94, 24
    s_lshr_b64 s[96:97], s[26:27], 8
    s_mov_b32 s95, s96
    s_waitcnt vmcnt(0)
    s_mov_b64 exec, 1
    ds_add_rtn_u32 v9, v8, v60 offset:520
    s_mov_b64 exec, -1
    s_waitcnt lgkmcnt(0)
    v_readfirstlane_b32 s67, v9
    s_nop 3
    s_cmp_lg_u32 s67, 5
    s_cbranch_scc1 K_poll_setup
    s_add_u32 s28, s24, 0x7f1000
    s_addc_u32 s29, s25, 0
    s_and_b32 s29, s29, 0xffff
    s_mov_b32 s30, 16384
    s_mov_b32 s31, 0x20000
    v_lshlrev_b32 v8, 11, v1
    v_mov_b32 v10, s94
    v_mov_b32 v11, s95
    s_lshl_b32 s67, s2, 3
    s_mov_b64 exec, 0xff
    buffer_store_dwordx2 v[10:11], v8, s[28:31], s67 offen sc1
    s_mov_b64 exec, -1
K_poll_setup:

    v_lshrrev_b32 v8, 4, v0
    v_lshlrev_b32 v8, 9, v8
    s_lshr_b32 s67, s71, 4
    s_lshl_b32 s67, s67, 15
    s_and_b32 s68, s71, 15
    s_lshl_b32 s68, s68, 3
    s_add_u32 s99, s67, s68
    s_mov_b32 s98, 0
    v_mov_b32 v9, 0xff000000
    s_barrier
K_poll:
    buffer_load_dwordx2 v[72:73], v8, s[44:47], s99 offen sc1
    buffer_load_dwordx2 v[74:75], v8, s[44:47], s99 offen offset:128 sc1
    buffer_load_dwordx2 v[76:77], v8, s[44:47], s99 offen offset:256 sc1
    buffer_load_dwordx2 v[78:79], v8, s[44:47], s99 offen offset:384 sc1
    s_add_u32 s98, s98, 1
    s_waitcnt vmcnt(0)
    v_xor_b32 v62, s94, v72
    v_xor_b32 v63, s94, v74
    v_xor_b32 v64, s94, v76
    v_xor_b32 v65, s94, v78
    v_or3_b32 v62, v62, v63, v64
    v_or_b32 v62, v62, v65
    v_and_b32 v62, v9, v62
    v_xor_b32 v63, s95, v73
    v_xor_b32 v64, s95, v75
    v_xor_b32 v65, s95, v77
    v_xor_b32 v66, s95, v79
    v_or3_b32 v62, v62, v63, v64
    v_or3_b32 v62, v62, v65, v66
    v_cmp_ne_u32 vcc, 0, v62
    s_cbranch_vccz K_poll_ok
    s_cmp_ge_u32 s98, 5000000
    s_cbranch_scc1 K_poll_fail
    s_sleep 3
    s_branch K_poll
K_poll_fail:
    v_mov_b32 v72, 0
    v_mov_b32 v74, 0
    v_mov_b32 v76, 0
    v_mov_b32 v78, 0
K_poll_ok:
    s_mov_b32 s90, 0
    s_mov_b32 s91, 20000
    s_mov_b32 s92, 40000
    s_mov_b32 s93, 60000
    v_bfe_u32 v80, v72, 12, 12
    v_and_b32 v84, 0xfff, v72
    v_add_u32 v84, v84, v5
    v_cmp_gt_u32 s[72:73], v80, v5
    v_lshl_add_u32 v84, v84, 3, v7
    v_bfe_u32 v81, v74, 12, 12
    v_and_b32 v85, 0xfff, v74
    v_add_u32 v85, v85, v5
    v_cmp_gt_u32 s[76:77], v81, v5
    v_lshl_add_u32 v85, v85, 3, v7
    v_bfe_u32 v82, v76, 12, 12
    v_and_b32 v86, 0xfff, v76
    v_add_u32 v86, v86, v5
    v_cmp_gt_u32 s[80:81], v82, v5
    v_lshl_add_u32 v86, v86, 3, v7
    v_bfe_u32 v83, v78, 12, 12
    v_and_b32 v87, 0xfff, v78
    v_add_u32 v87, v87, v5
    v_cmp_gt_u32 s[84:85], v83, v5
    v_lshl_add_u32 v87, v87, 3, v7
    s_mov_b64 exec, s[72:73]
    buffer_load_dwordx2 v[28:29], v84, s[48:51], s90 offen sc1
    s_mov_b64 exec, s[76:77]
    buffer_load_dwordx2 v[32:33], v85, s[48:51], s91 offen sc1
    s_mov_b64 exec, s[80:81]
    buffer_load_dwordx2 v[36:37], v86, s[48:51], s92 offen sc1
    s_mov_b64 exec, s[84:85]
    buffer_load_dwordx2 v[40:41], v87, s[48:51], s93 offen sc1
    s_mov_b64 exec, -1
    v_lshrrev_b32 v12, 4, v0
    v_add_u32 v12, s64, v12
    v_lshlrev_b32 v12, 7, v12
    v_lshl_add_u32 v12, v5, 3, v12
    v_lshlrev_b32 v13, 1, v1
    buffer_load_ushort v26, v13, s[36:39], 0 offen
    buffer_load_dwordx2 v[24:25], v12, s[40:43], 0 offen
    v_max3_u32 v62, v80, v81, v82
    v_max_u32 v62, v62, v83
    v_cmp_lt_u32 vcc, 16, v62
    s_mov_b64 s[88:89], vcc
    s_cbranch_vccz K_nok1
    v_cmp_gt_u32 s[74:75], v80, v6
    v_cmp_gt_u32 s[78:79], v81, v6
    v_cmp_gt_u32 s[82:83], v82, v6
    v_cmp_gt_u32 s[86:87], v83, v6
    s_nop 1
    s_mov_b64 exec, s[74:75]
    s_cbranch_execz K_nok1_0
    buffer_load_dwordx2 v[30:31], v84, s[48:51], s90 offen offset:128 sc1
K_nok1_0:
    s_mov_b64 exec, s[78:79]
    s_cbranch_execz K_nok1_1
    buffer_load_dwordx2 v[34:35], v85, s[48:51], s91 offen offset:128 sc1
K_nok1_1:
    s_mov_b64 exec, s[82:83]
    s_cbranch_execz K_nok1_2
    buffer_load_dwordx2 v[38:39], v86, s[48:51], s92 offen offset:128 sc1
K_nok1_2:
    s_mov_b64 exec, s[86:87]
    s_cbranch_execz K_nok1_3
    buffer_load_dwordx2 v[42:43], v87, s[48:51], s93 offen offset:128 sc1
K_nok1_3:
    s_mov_b64 exec, -1
    v_cmp_lt_u32 vcc, 32, v62
    s_cbranch_vccz K_nok1
    v_mov_b32 v62, 0
    ds_write_b32 v62, v60 offset:512
K_nok1:
    s_cmp_lg_u32 s3, 15
    s_cbranch_scc1 K_notf
    s_add_u32 s32, s24, 0x7f1000
    s_addc_u32 s33, s25, 0
    s_and_b32 s33, s33, 0xffff
    s_mov_b32 s34, 16384
    s_mov_b32 s35, 0x20000
    s_and_b32 s70, s2, 7
    s_lshl_b32 s70, s70, 11
    v_lshlrev_b32 v100, 5, v1
    v_mov_b32 v101, 0xff000000
    s_mov_b32 s98, 0
K_tfpoll:
    buffer_load_dwordx4 v[88:91], v100, s[32:35], s70 offen sc1
    buffer_load_dwordx4 v[92:95], v100, s[32:35], s70 offen offset:16 sc1
    s_add_u32 s98, s98, 1
    s_waitcnt vmcnt(0)
    v_xor_b32 v62, s94, v88
    v_xor_b32 v63, s94, v90
    v_xor_b32 v64, s94, v92
    v_xor_b32 v65, s94, v94
    v_or3_b32 v62, v62, v63, v64
    v_or_b32 v62, v62, v65
    v_and_b32 v62, v101, v62
    v_xor_b32 v63, s95, v89
    v_xor_b32 v64, s95, v91
    v_xor_b32 v65, s95, v93
    v_xor_b32 v66, s95, v95
    v_or3_b32 v62, v62, v63, v64
    v_or3_b32 v62, v62, v65, v66
    v_cmp_ne_u32 vcc, 0, v62
    s_cbranch_vccz K_notf
    s_cmp_ge_u32 s98, 5000000
    s_cbranch_scc1 K_notf
    s_sleep 1
    s_branch K_tfpoll
K_notf:
    s_waitcnt vmcnt(0)
    v_lshlrev_b32 v26, 16, v26
    v_mul_f32 v26, 0xbfb8aa3b, v26
    v_lshlrev_b32 v44, 2, v28
    v_subrev_u32 v44, s66, v44
    v_and_b32 v44, 0xfc, v44
    s_mov_b64 exec, s[72:73]
    ds_add_rtn_u32 v52, v44, v60 offset:0
    s_mov_b64 exec, -1
    v_lshlrev_b32 v46, 2, v32
    v_subrev_u32 v46, s66, v46
    v_and_b32 v46, 0xfc, v46
    s_mov_b64 exec, s[76:77]
    ds_add_rtn_u32 v54, v46, v60 offset:0
    s_mov_b64 exec, -1
    v_lshlrev_b32 v48, 2, v36
    v_subrev_u32 v48, s66, v48
    v_and_b32 v48, 0xfc, v48
    s_mov_b64 exec, s[80:81]
    ds_add_rtn_u32 v56, v48, v60 offset:0
    s_mov_b64 exec, -1
    v_lshlrev_b32 v50, 2, v40
    v_subrev_u32 v50, s66, v50
    v_and_b32 v50, 0xfc, v50
    s_mov_b64 exec, s[84:85]
    ds_add_rtn_u32 v58, v50, v60 offset:0
    s_mov_b64 exec, -1
    s_cmp_eq_u64 s[88:89], 0
    s_cbranch_scc1 K_noh1
    v_lshlrev_b32 v45, 2, v30
    v_subrev_u32 v45, s66, v45
    v_and_b32 v45, 0xfc, v45
    s_mov_b64 exec, s[74:75]
    ds_add_rtn_u32 v53, v45, v60 offset:0
    s_mov_b64 exec, -1
    v_lshlrev_b32 v47, 2, v34
    v_subrev_u32 v47, s66, v47
    v_and_b32 v47, 0xfc, v47
    s_mov_b64 exec, s[78:79]
    ds_add_rtn_u32 v55, v47, v60 offset:0
    s_mov_b64 exec, -1
    v_lshlrev_b32 v49, 2, v38
    v_subrev_u32 v49, s66, v49
    v_and_b32 v49, 0xfc, v49
    s_mov_b64 exec, s[82:83]
    ds_add_rtn_u32 v57, v49, v60 offset:0
    s_mov_b64 exec, -1
    v_lshlrev_b32 v51, 2, v42
    v_subrev_u32 v51, s66, v51
    v_and_b32 v51, 0xfc, v51
    s_mov_b64 exec, s[86:87]
    ds_add_rtn_u32 v59, v51, v60 offset:0
    s_mov_b64 exec, -1
K_noh1:
    s_waitcnt lgkmcnt(0)
    s_barrier
    ds_read_b32 v70, v4 offset:0
    v_mov_b32 v62, 0
    ds_read_b32 v63, v62 offset:512

    s_sub_u32 s68, s3, 0
    s_cmp_ge_u32 s68, 4
    s_cbranch_scc1 K_nops
    s_lshr_b32 s67, s2, 3
    s_mul_i32 s67, s67, 81920
    s_lshl_b32 s68, s68, 13
    s_add_u32 s67, s67, s68
    v_lshlrev_b32 v8, 7, v1
    buffer_load_dword v104, v8, s[56:59], s67 offen sc1
K_nops:
    s_or_b32 s67, s2, s3
    s_cmp_lg_u32 s67, 0
    s_cbranch_scc1 K_noep
    s_add_u32 s28, s24, 0x7f0000
    s_addc_u32 s29, s25, 0
    s_and_b32 s29, s29, 0xffff
    s_mov_b32 s30, 8
    s_mov_b32 s31, 0x20000
    v_mov_b32 v8, s26
    v_mov_b32 v9, s27
    s_mov_b64 exec, 1
    buffer_store_dwordx2 v[8:9], v62, s[28:31], 0 offen
    s_mov_b64 exec, -1
K_noep:
    s_waitcnt lgkmcnt(0)
    v_add_u32 v70, 3, v70
    v_readfirstlane_b32 s67, v63
    v_lshrrev_b32 v70, 2, v70
    v_mov_b32 v71, v70
    v_and_b32 v28, 0xffffff00, v28
    v_and_b32 v30, 0xffffff00, v30
    v_add_u32_dpp v70, v70, v70 row_shr:1 row_mask:0xf bank_mask:0xf bound_ctrl:1
    v_and_b32 v32, 0xffffff00, v32
    v_and_b32 v34, 0xffffff00, v34
    v_add_u32_dpp v70, v70, v70 row_shr:2 row_mask:0xf bank_mask:0xf bound_ctrl:1
    v_and_b32 v36, 0xffffff00, v36
    v_and_b32 v38, 0xffffff00, v38
    v_add_u32_dpp v70, v70, v70 row_shr:4 row_mask:0xf bank_mask:0xf bound_ctrl:1
    v_and_b32 v40, 0xffffff00, v40
    v_and_b32 v42, 0xffffff00, v42
    v_add_u32_dpp v70, v70, v70 row_shr:8 row_mask:0xf bank_mask:0xf bound_ctrl:1
    s_lshl_b32 s69, 1, s3
    v_mov_b32 v64, s69
    v_add_u32_dpp v70, v70, v70 row_bcast:15 row_mask:0xa bank_mask:0xf
    s_nop 1
    v_add_u32_dpp v70, v70, v70 row_bcast:31 row_mask:0xc bank_mask:0xf
    v_sub_u32 v65, v70, v71
    v_lshlrev_b32 v71, 2, v65
    v_readlane_b32 s4, v70, 63
    s_cmp_lg_u32 s67, 0
    s_cbranch_scc1 K_slow
    ds_bpermute_b32 v80, v44, v71
    ds_bpermute_b32 v82, v46, v71
    ds_bpermute_b32 v84, v48, v71
    ds_bpermute_b32 v86, v50, v71
    s_cmp_gt_u32 s4, 768
    s_cbranch_scc1 K_slow
    s_mul_i32 s5, s4, s3
    s_lshr_b32 s5, s5, 4
    s_add_u32 s67, s3, 1
    s_mul_i32 s6, s4, s67
    s_lshr_b32 s6, s6, 4
    v_cmp_ge_u32 vcc, s5, v70
    s_bcnt1_i32_b64 s7, vcc
    v_cmp_lt_u32 s[28:29], s5, v70
    v_cmp_gt_u32 s[30:31], s6, v65
    v_cmp_gt_u32 vcc, v70, v65
    v_readlane_b32 s8, v70, s7
    s_and_b64 s[28:29], s[28:29], s[30:31]
    s_and_b64 s[28:29], s[28:29], vcc
    s_cmp_lt_u32 s5, s6
    s_cselect_b64 exec, s[28:29], 0
    ds_or_b32 v4, v64 offset:256
    s_mov_b64 exec, -1
    s_waitcnt lgkmcnt(0)
    v_add_lshl_u32 v80, v80, v52, 2
    v_add_lshl_u32 v82, v82, v54, 2
    v_add_lshl_u32 v84, v84, v56, 2
    v_add_lshl_u32 v86, v86, v58, 2
    s_mov_b64 exec, s[72:73]
    ds_write_b32 v80, v28 offset:2816
    ds_write_b32 v80, v29 offset:15616
    s_mov_b64 exec, s[76:77]
    ds_write_b32 v82, v32 offset:2816
    ds_write_b32 v82, v33 offset:15616
    s_mov_b64 exec, s[80:81]
    ds_write_b32 v84, v36 offset:2816
    ds_write_b32 v84, v37 offset:15616
    s_mov_b64 exec, s[84:85]
    ds_write_b32 v86, v40 offset:2816
    ds_write_b32 v86, v41 offset:15616
    s_mov_b64 exec, -1
    s_cmp_eq_u64 s[88:89], 0
    s_cbranch_scc1 K_nop1
    ds_bpermute_b32 v81, v45, v71
    ds_bpermute_b32 v83, v47, v71
    ds_bpermute_b32 v85, v49, v71
    ds_bpermute_b32 v87, v51, v71
    s_waitcnt lgkmcnt(0)
    v_add_lshl_u32 v81, v81, v53, 2
    v_add_lshl_u32 v83, v83, v55, 2
    v_add_lshl_u32 v85, v85, v57, 2
    v_add_lshl_u32 v87, v87, v59, 2
    s_mov_b64 exec, s[74:75]
    ds_write_b32 v81, v30 offset:2816
    ds_write_b32 v81, v31 offset:15616
    s_mov_b64 exec, s[78:79]
    ds_write_b32 v83, v34 offset:2816
    ds_write_b32 v83, v35 offset:15616
    s_mov_b64 exec, s[82:83]
    ds_write_b32 v85, v38 offset:2816
    ds_write_b32 v85, v39 offset:15616
    s_mov_b64 exec, s[86:87]
    ds_write_b32 v87, v42 offset:2816
    ds_write_b32 v87, v43 offset:15616
    s_mov_b64 exec, -1
K_nop1:
    s_mul_i32 s67, s7, 272
    v_add_u32 v14, s67, v4
    s_add_u32 s68, s7, s3
    s_lshl_b32 s68, s68, 9
    v_add_u32 v27, s68, v4
    s_lshl_b32 s67, s5, 4
    v_mov_b32 v15, s67
    ds_read_b32 v8, v14 offset:28416
    ds_read_b32 v9, v14 offset:28688
    s_min_u32 s9, s8, s6
    s_sub_u32 s10, s9, s5
    s_mov_b32 s12, 0x5f000000
    s_mov_b32 s13, 0x5f000000
    s_mov_b32 s14, 0x00003f80
    s_mov_b32 s15, 0
    v_mov_b64 v[10:11], 0
    v_mov_b64 v[12:13], 0
    s_waitcnt lgkmcnt(0)
    s_barrier
    s_cmp_ge_u32 s5, s6
    s_cbranch_scc1 K_main_done
    s_setprio 3
    ds_read_b128 v[16:19], v15 offset:2816
    ds_read_b128 v[48:51], v15 offset:2832
    ds_read_b128 v[52:55], v15 offset:2848
    ds_read_b128 v[20:23], v15 offset:15616
    s_waitcnt lgkmcnt(3)
    buffer_load_dword v32, v16, s[52:55], 0 offen sc1
    buffer_load_dword v33, v17, s[52:55], 0 offen sc1
    buffer_load_dword v34, v18, s[52:55], 0 offen sc1
    buffer_load_dword v35, v19, s[52:55], 0 offen sc1
    s_waitcnt lgkmcnt(2)
    buffer_load_dword v36, v48, s[52:55], 0 offen sc1
    buffer_load_dword v37, v49, s[52:55], 0 offen sc1
    buffer_load_dword v38, v50, s[52:55], 0 offen sc1
    buffer_load_dword v39, v51, s[52:55], 0 offen sc1
    s_waitcnt lgkmcnt(1)
    buffer_load_dword v40, v52, s[52:55], 0 offen sc1
    buffer_load_dword v41, v53, s[52:55], 0 offen sc1
    buffer_load_dword v42, v54, s[52:55], 0 offen sc1
    buffer_load_dword v43, v55, s[52:55], 0 offen sc1
    ds_read_b128 v[16:19], v15 offset:2864
.p2align 3
K_loop:
    s_waitcnt lgkmcnt(0)
    s_sub_u32 s10, s10, 1
    buffer_load_dword v44, v16, s[52:55], 0 offen sc1
    buffer_load_dword v45, v17, s[52:55], 0 offen sc1
    buffer_load_dword v46, v18, s[52:55], 0 offen sc1
    buffer_load_dword v47, v19, s[52:55], 0 offen sc1
    ds_read_b128 v[16:19], v15 offset:2880
    ds_read_b128 v[28:31], v15 offset:15632
    s_cbranch_scc1 K_h0
K_r0:
    s_waitcnt vmcnt(12)
    v_pk_fma_f32 v[48:49], v[20:21], v[26:27], v[8:9] op_sel_hi:[1,0,0]
    v_pk_fma_f32 v[50:51], v[22:23], v[26:27], v[8:9] op_sel_hi:[1,0,0]
    v_dot2c_f32_bf16 v48, s14, v32
    v_dot2c_f32_bf16 v49, s14, v33
    v_dot2c_f32_bf16 v50, s14, v34
    v_dot2c_f32_bf16 v51, s14, v35
    v_exp_f32_e64 v48, v48 clamp
    v_exp_f32_e64 v49, v49 clamp
    v_exp_f32_e64 v50, v50 clamp
    v_exp_f32_e64 v51, v51 clamp
    v_pk_fma_f32 v[52:53], v[48:49], s[12:13], 1.0 op_sel_hi:[1,0,0]
    v_pk_fma_f32 v[54:55], v[50:51], s[12:13], 1.0 op_sel_hi:[1,0,0]
    v_pk_mul_f32 v[56:57], v[52:53], v[54:55]
    v_pk_add_f32 v[58:59], v[52:53], v[54:55]
    v_rcp_f32 v64, v56
    v_rcp_f32 v65, v57
    v_pk_mul_f32 v[62:63], v[54:55], v[32:33]
    v_pk_fma_f32 v[62:63], v[52:53], v[34:35], v[62:63]
    v_pk_fma_f32 v[10:11], v[58:59], v[64:65], v[10:11]
    v_pk_fma_f32 v[12:13], v[62:63], v[64:65], v[12:13]
    s_waitcnt lgkmcnt(0)
    s_sub_u32 s10, s10, 1
    buffer_load_dword v32, v16, s[52:55], 0 offen sc1
    buffer_load_dword v33, v17, s[52:55], 0 offen sc1
    buffer_load_dword v34, v18, s[52:55], 0 offen sc1
    buffer_load_dword v35, v19, s[52:55], 0 offen sc1
    ds_read_b128 v[16:19], v15 offset:2896
    ds_read_b128 v[20:23], v15 offset:15648
    s_cbranch_scc1 K_h1
K_r1:
    s_waitcnt vmcnt(12)
    v_pk_fma_f32 v[48:49], v[28:29], v[26:27], v[8:9] op_sel_hi:[1,0,0]
    v_pk_fma_f32 v[50:51], v[30:31], v[26:27], v[8:9] op_sel_hi:[1,0,0]
    v_dot2c_f32_bf16 v48, s14, v36
    v_dot2c_f32_bf16 v49, s14, v37
    v_dot2c_f32_bf16 v50, s14, v38
    v_dot2c_f32_bf16 v51, s14, v39
    v_exp_f32_e64 v48, v48 clamp
    v_exp_f32_e64 v49, v49 clamp
    v_exp_f32_e64 v50, v50 clamp
    v_exp_f32_e64 v51, v51 clamp
    v_pk_fma_f32 v[52:53], v[48:49], s[12:13], 1.0 op_sel_hi:[1,0,0]
    v_pk_fma_f32 v[54:55], v[50:51], s[12:13], 1.0 op_sel_hi:[1,0,0]
    v_pk_mul_f32 v[56:57], v[52:53], v[54:55]
    v_pk_add_f32 v[58:59], v[52:53], v[54:55]
    v_rcp_f32 v64, v56
    v_rcp_f32 v65, v57
    v_pk_mul_f32 v[62:63], v[54:55], v[36:37]
    v_pk_fma_f32 v[62:63], v[52:53], v[38:39], v[62:63]
    v_pk_fma_f32 v[10:11], v[58:59], v[64:65], v[10:11]
    v_pk_fma_f32 v[12:13], v[62:63], v[64:65], v[12:13]
    s_waitcnt lgkmcnt(0)
    s_sub_u32 s10, s10, 1
    buffer_load_dword v36, v16, s[52:55], 0 offen sc1
    buffer_load_dword v37, v17, s[52:55], 0 offen sc1
    buffer_load_dword v38, v18, s[52:55], 0 offen sc1
    buffer_load_dword v39, v19, s[52:55], 0 offen sc1
    ds_read_b128 v[16:19], v15 offset:2912
    ds_read_b128 v[28:31], v15 offset:15664
    s_cbranch_scc1 K_h2
K_r2:
    s_waitcnt vmcnt(12)
    v_pk_fma_f32 v[48:49], v[20:21], v[26:27], v[8:9] op_sel_hi:[1,0,0]
    v_pk_fma_f32 v[50:51], v[22:23], v[26:27], v[8:9] op_sel_hi:[1,0,0]
    v_dot2c_f32_bf16 v48, s14, v40
    v_dot2c_f32_bf16 v49, s14, v41
    v_dot2c_f32_bf16 v50, s14, v42
    v_dot2c_f32_bf16 v51, s14, v43
    v_exp_f32_e64 v48, v48 clamp
    v_exp_f32_e64 v49, v49 clamp
    v_exp_f32_e64 v50, v50 clamp
    v_exp_f32_e64 v51, v51 clamp
    v_pk_fma_f32 v[52:53], v[48:49], s[12:13], 1.0 op_sel_hi:[1,0,0]
    v_pk_fma_f32 v[54:55], v[50:51], s[12:13], 1.0 op_sel_hi:[1,0,0]
    v_pk_mul_f32 v[56:57], v[52:53], v[54:55]
    v_pk_add_f32 v[58:59], v[52:53], v[54:55]
    v_rcp_f32 v64, v56
    v_rcp_f32 v65, v57
    v_pk_mul_f32 v[62:63], v[54:55], v[40:41]
    v_pk_fma_f32 v[62:63], v[52:53], v[42:43], v[62:63]
    v_pk_fma_f32 v[10:11], v[58:59], v[64:65], v[10:11]
    v_pk_fma_f32 v[12:13], v[62:63], v[64:65], v[12:13]
    s_waitcnt lgkmcnt(0)
    s_sub_u32 s10, s10, 1
    buffer_load_dword v40, v16, s[52:55], 0 offen sc1
    buffer_load_dword v41, v17, s[52:55], 0 offen sc1
    buffer_load_dword v42, v18, s[52:55], 0 offen sc1
    buffer_load_dword v43, v19, s[52:55], 0 offen sc1
    ds_read_b128 v[16:19], v15 offset:2928
    ds_read_b128 v[20:23], v15 offset:15680
    s_cbranch_scc1 K_h3
K_r3:
    s_waitcnt vmcnt(12)
    v_pk_fma_f32 v[48:49], v[28:29], v[26:27], v[8:9] op_sel_hi:[1,0,0]
    v_pk_fma_f32 v[50:51], v[30:31], v[26:27], v[8:9] op_sel_hi:[1,0,0]
    v_dot2c_f32_bf16 v48, s14, v44
    v_dot2c_f32_bf16 v49, s14, v45
    v_dot2c_f32_bf16 v50, s14, v46
    v_dot2c_f32_bf16 v51, s14, v47
    v_exp_f32_e64 v48, v48 clamp
    v_exp_f32_e64 v49, v49 clamp
    v_exp_f32_e64 v50, v50 clamp
    v_exp_f32_e64 v51, v51 clamp
    v_pk_fma_f32 v[52:53], v[48:49], s[12:13], 1.0 op_sel_hi:[1,0,0]
    v_pk_fma_f32 v[54:55], v[50:51], s[12:13], 1.0 op_sel_hi:[1,0,0]
    v_pk_mul_f32 v[56:57], v[52:53], v[54:55]
    v_pk_add_f32 v[58:59], v[52:53], v[54:55]
    v_rcp_f32 v64, v56
    v_rcp_f32 v65, v57
    v_pk_mul_f32 v[62:63], v[54:55], v[44:45]
    v_pk_fma_f32 v[62:63], v[52:53], v[46:47], v[62:63]
    v_pk_fma_f32 v[10:11], v[58:59], v[64:65], v[10:11]
    v_pk_fma_f32 v[12:13], v[62:63], v[64:65], v[12:13]
    v_add_u32 v15, 64, v15
    s_add_u32 s15, s15, 1
    s_cmp_eq_u32 s15, 4
    s_cbranch_scc1 K_p2
    s_cmp_eq_u32 s15, 7
    s_cbranch_scc1 K_p1
    s_cmp_eq_u32 s15, 9
    s_cbranch_scc0 K_loop
    s_setprio 0
    s_branch K_loop
K_p2:
    s_setprio 2
    s_branch K_loop
K_p1:
    s_setprio 1
    s_branch K_loop
K_h0:
    v_add_f32 v66, v10, v11
    v_add_f32 v67, v12, v13
    s_add_u32 s7, s7, 1
    ds_write_b32 v27, v66 offset:41472
    ds_write_b32 v27, v67 offset:41728
    s_cmp_ge_u32 s9, s6
    s_cbranch_scc1 K_main_done
    v_readlane_b32 s8, v70, s7
    v_mov_b64 v[10:11], 0
    v_mov_b64 v[12:13], 0
    v_mov_b32 v8, v9
    v_add_u32 v14, 272, v14
    v_add_u32 v27, 512, v27
    s_cmp_eq_u32 s8, s9
    s_cbranch_scc1 K_hs0
    ds_read_b32 v9, v14 offset:28688
K_hr0:
    s_mov_b32 s67, s9
    s_min_u32 s9, s8, s6
    s_sub_u32 s10, s9, s67
    s_sub_u32 s10, s10, 1
    s_branch K_r0
K_hs0:
    s_add_u32 s7, s7, 1
    v_readlane_b32 s8, v70, s7
    v_add_u32 v14, 272, v14
    v_add_u32 v27, 512, v27
    s_nop 1
    s_cmp_eq_u32 s8, s9
    s_cbranch_scc1 K_hs0
    ds_read_b32 v8, v14 offset:28416
    ds_read_b32 v9, v14 offset:28688
    s_waitcnt lgkmcnt(0)
    s_branch K_hr0
K_h1:
    v_add_f32 v66, v10, v11
    v_add_f32 v67, v12, v13
    s_add_u32 s7, s7, 1
    ds_write_b32 v27, v66 offset:41472
    ds_write_b32 v27, v67 offset:41728
    s_cmp_ge_u32 s9, s6
    s_cbranch_scc1 K_main_done
    v_readlane_b32 s8, v70, s7
    v_mov_b64 v[10:11], 0
    v_mov_b64 v[12:13], 0
    v_mov_b32 v8, v9
    v_add_u32 v14, 272, v14
    v_add_u32 v27, 512, v27
    s_cmp_eq_u32 s8, s9
    s_cbranch_scc1 K_hs1
    ds_read_b32 v9, v14 offset:28688
K_hr1:
    s_mov_b32 s67, s9
    s_min_u32 s9, s8, s6
    s_sub_u32 s10, s9, s67
    s_sub_u32 s10, s10, 1
    s_branch K_r1
K_hs1:
    s_add_u32 s7, s7, 1
    v_readlane_b32 s8, v70, s7
    v_add_u32 v14, 272, v14
    v_add_u32 v27, 512, v27
    s_nop 1
    s_cmp_eq_u32 s8, s9
    s_cbranch_scc1 K_hs1
    ds_read_b32 v8, v14 offset:28416
    ds_read_b32 v9, v14 offset:28688
    s_waitcnt lgkmcnt(0)
    s_branch K_hr1
K_h2:
    v_add_f32 v66, v10, v11
    v_add_f32 v67, v12, v13
    s_add_u32 s7, s7, 1
    ds_write_b32 v27, v66 offset:41472
    ds_write_b32 v27, v67 offset:41728
    s_cmp_ge_u32 s9, s6
    s_cbranch_scc1 K_main_done
    v_readlane_b32 s8, v70, s7
    v_mov_b64 v[10:11], 0
    v_mov_b64 v[12:13], 0
    v_mov_b32 v8, v9
    v_add_u32 v14, 272, v14
    v_add_u32 v27, 512, v27
    s_cmp_eq_u32 s8, s9
    s_cbranch_scc1 K_hs2
    ds_read_b32 v9, v14 offset:28688
K_hr2:
    s_mov_b32 s67, s9
    s_min_u32 s9, s8, s6
    s_sub_u32 s10, s9, s67
    s_sub_u32 s10, s10, 1
    s_branch K_r2
K_hs2:
    s_add_u32 s7, s7, 1
    v_readlane_b32 s8, v70, s7
    v_add_u32 v14, 272, v14
    v_add_u32 v27, 512, v27
    s_nop 1
    s_cmp_eq_u32 s8, s9
    s_cbranch_scc1 K_hs2
    ds_read_b32 v8, v14 offset:28416
    ds_read_b32 v9, v14 offset:28688
    s_waitcnt lgkmcnt(0)
    s_branch K_hr2
K_h3:
    v_add_f32 v66, v10, v11
    v_add_f32 v67, v12, v13
    s_add_u32 s7, s7, 1
    ds_write_b32 v27, v66 offset:41472
    ds_write_b32 v27, v67 offset:41728
    s_cmp_ge_u32 s9, s6
    s_cbranch_scc1 K_main_done
    v_readlane_b32 s8, v70, s7
    v_mov_b64 v[10:11], 0
    v_mov_b64 v[12:13], 0
    v_mov_b32 v8, v9
    v_add_u32 v14, 272, v14
    v_add_u32 v27, 512, v27
    s_cmp_eq_u32 s8, s9
    s_cbranch_scc1 K_hs3
    ds_read_b32 v9, v14 offset:28688
K_hr3:
    s_mov_b32 s67, s9
    s_min_u32 s9, s8, s6
    s_sub_u32 s10, s9, s67
    s_sub_u32 s10, s10, 1
    s_branch K_r3
K_hs3:
    s_add_u32 s7, s7, 1
    v_readlane_b32 s8, v70, s7
    v_add_u32 v14, 272, v14
    v_add_u32 v27, 512, v27
    s_nop 1
    s_cmp_eq_u32 s8, s9
    s_cbranch_scc1 K_hs3
    ds_read_b32 v8, v14 offset:28416
    ds_read_b32 v9, v14 offset:28688
    s_waitcnt lgkmcnt(0)
    s_branch K_hr3
K_slow:
    s_add_u32 s32, s24, 0x7f1000
    s_addc_u32 s33, s25, 0
    s_and_b32 s33, s33, 0xffff
    s_mov_b32 s34, 16384
    s_mov_b32 s35, 0x20000
    s_and_b32 s70, s2, 7
    s_lshl_b32 s70, s70, 11
    v_lshlrev_b32 v100, 5, v1
    v_mov_b32 v101, 0xff000000
    s_mov_b32 s98, 0
K_s_tf:
    buffer_load_dwordx4 v[88:91], v100, s[32:35], s70 offen sc1
    buffer_load_dwordx4 v[92:95], v100, s[32:35], s70 offen offset:16 sc1
    s_add_u32 s98, s98, 1
    s_waitcnt vmcnt(0)
    v_xor_b32 v62, s94, v88
    v_xor_b32 v63, s94, v90
    v_xor_b32 v64, s94, v92
    v_xor_b32 v65, s94, v94
    v_or3_b32 v62, v62, v63, v64
    v_or_b32 v62, v62, v65
    v_and_b32 v62, v101, v62
    v_xor_b32 v63, s95, v89
    v_xor_b32 v64, s95, v91
    v_xor_b32 v65, s95, v93
    v_xor_b32 v66, s95, v95
    v_or3_b32 v62, v62, v63, v64
    v_or3_b32 v62, v62, v65, v66
    v_cmp_ne_u32 vcc, 0, v62
    s_cbranch_vccz K_s_go
    s_cmp_ge_u32 s98, 5000000
    s_cbranch_scc1 K_s_go
    s_sleep 4
    s_branch K_s_tf
K_s_go:
    s_mov_b32 s12, 0x5f000000
    s_mov_b32 s14, 0x00003f80
    s_mov_b32 s7, s3
    v_mov_b32 v62, 0
K_s_node:
    s_mov_b32 s70, 1
    s_cmp_ge_u32 s7, s65
    s_cbranch_scc1 K_main_done2
    s_mul_i32 s67, s7, 272
    v_add_u32 v14, s67, v4
    ds_read_b32 v8, v14 offset:28416
    v_mov_b32 v10, 0
    v_mov_b32 v12, 0
    s_mov_b32 s4, 0
    s_waitcnt lgkmcnt(0)
K_s_prod:
    s_lshl_b32 s67, s4, 7
    s_add_u32 s67, s67, s99
    buffer_load_dword v48, v62, s[44:47], s67 offen sc1
    s_waitcnt vmcnt(0)
    v_readfirstlane_b32 s5, v48
    s_nop 3
    s_and_b32 s6, s5, 0xfff
    s_bfe_u32 s5, s5, 0xc000c
    s_mul_i32 s67, s4, 2500
    s_add_u32 s6, s6, s67
    s_lshl_b32 s6, s6, 3
K_s_ent:
    s_cmp_eq_u32 s5, 0
    s_cbranch_scc1 K_s_prod_next
    buffer_load_dwordx2 v[48:49], v62, s[48:51], s6 offen sc1
    s_waitcnt vmcnt(0)
    v_readfirstlane_b32 s8, v48
    s_nop 3
    s_sub_u32 s67, s8, s64
    s_and_b32 s67, s67, 63
    s_cmp_lg_u32 s67, s7
    s_cbranch_scc1 K_s_ent_next
    s_and_b32 s67, s8, 0xffffff00
    buffer_load_dword v50, off, s[52:55], s67 sc1
    v_fma_f32 v48, v49, v26, v8
    s_waitcnt vmcnt(0)
    v_dot2c_f32_bf16 v48, s14, v50
    s_nop 2
    v_exp_f32_e64 v48, v48 clamp
    s_nop 0
    v_fma_f32 v48, v48, s12, 1.0
    v_rcp_f32 v48, v48
    s_nop 0
    v_add_f32 v10, v10, v48
    v_fmac_f32 v12, v48, v50
K_s_ent_next:
    s_add_u32 s6, s6, 8
    s_sub_u32 s5, s5, 1
    s_branch K_s_ent
K_s_prod_next:
    s_add_u32 s4, s4, 1
    s_cmp_lt_u32 s4, 256
    s_cbranch_scc1 K_s_prod
    s_lshl_b32 s67, s7, 9
    v_add_u32 v68, s67, v4
    ds_write_b32 v68, v10 offset:41472
    ds_write_b32 v68, v12 offset:41728
    s_lshl_b32 s67, s7, 2
    v_mov_b32 v69, s67
    s_mov_b64 exec, 1
    ds_write_b32 v69, v60 offset:256
    s_mov_b64 exec, -1
    s_add_u32 s7, s7, 16
    s_branch K_s_node
K_main_done:
    s_mov_b32 s70, 0
K_main_done2:
    s_setprio 0
    s_waitcnt vmcnt(0) lgkmcnt(0)
    s_cmp_ge_u32 s3, 10
    s_cbranch_scc1 K_e_wait
    v_lshrrev_b32 v8, 4, v0
    v_and_b32 v9, 15, v0
    v_lshlrev_b32 v12, 2, v8
    ds_read_b32 v10, v12 offset:256
    v_mul_u32_u24 v13, 272, v8
    v_lshl_add_u32 v13, v9, 4, v13
    v_add_u32 v13, 70144, v13
    ds_read_b128 v[36:39], v13
    v_lshlrev_b32 v28, 16, v24
    v_and_b32 v29, 0xffff0000, v24
    v_lshlrev_b32 v30, 16, v25
    v_and_b32 v31, 0xffff0000, v25
    v_lshlrev_b32 v14, 4, v9
    v_add_u32 v35, 120064, v14
    v_lshl_add_u32 v14, v8, 9, v14
    v_add_u32 v14, 41472, v14
    v_mov_b32 v13, v12
    v_add_u32 v12, s64, v8
    v_lshlrev_b32 v12, 7, v12
    v_lshl_add_u32 v12, v9, 3, v12
    s_waitcnt lgkmcnt(0)
    v_ffbl_b32 v11, v10
    v_cmp_ne_u32 vcc, 0, v10
    v_lshl_add_u32 v11, v11, 9, v14
    v_add_u32 v33, -1, v10
    v_cndmask_b32 v15, v35, v11, vcc
    v_and_b32 v10, v10, v33
    v_ffbl_b32 v11, v10
    v_cmp_ne_u32 vcc, 0, v10
    v_lshl_add_u32 v11, v11, 9, v14
    v_add_u32 v33, -1, v10
    v_cndmask_b32 v34, v35, v11, vcc
    v_and_b32 v10, v10, v33
K_e_wait:
    s_barrier
    s_cmp_ge_u32 s3, 10
    s_cbranch_scc1 K_exit
    s_cmp_eq_u32 s70, 0
    s_cbranch_scc1 K_e_fast
    ds_read_b32 v10, v13 offset:256
    s_waitcnt lgkmcnt(0)
    v_ffbl_b32 v11, v10
    v_cmp_ne_u32 vcc, 0, v10
    v_lshl_add_u32 v11, v11, 9, v14
    v_add_u32 v33, -1, v10
    v_cndmask_b32 v15, v35, v11, vcc
    v_and_b32 v10, v10, v33
    v_ffbl_b32 v11, v10
    v_cmp_ne_u32 vcc, 0, v10
    v_lshl_add_u32 v11, v11, 9, v14
    v_add_u32 v33, -1, v10
    v_cndmask_b32 v34, v35, v11, vcc
    v_and_b32 v10, v10, v33
K_e_fast:
    ds_read_b128 v[16:19], v15
    ds_read_b128 v[20:23], v15 offset:256
    ds_read_b128 v[40:43], v34
    ds_read_b128 v[44:47], v34 offset:256
    s_waitcnt lgkmcnt(0)
K_e_loop:
    v_pk_add_f32 v[16:17], v[16:17], v[40:41]
    v_pk_add_f32 v[18:19], v[18:19], v[42:43]
    v_pk_add_f32 v[20:21], v[20:21], v[44:45]
    v_pk_add_f32 v[22:23], v[22:23], v[46:47]
    v_cmp_ne_u32 vcc, 0, v10
    s_cbranch_vccz K_e_end
    v_ffbl_b32 v11, v10
    v_lshl_add_u32 v11, v11, 9, v14
    v_add_u32 v33, -1, v10
    v_cndmask_b32 v34, v35, v11, vcc
    v_and_b32 v10, v10, v33
    ds_read_b128 v[40:43], v34
    ds_read_b128 v[44:47], v34 offset:256
    s_waitcnt lgkmcnt(0)
    s_branch K_e_loop
K_e_end:
    v_add_f32 v16, 0x358637bd, v16
    v_add_f32 v17, 0x358637bd, v17
    v_add_f32 v18, 0x358637bd, v18
    v_add_f32 v19, 0x358637bd, v19
    v_rcp_f32 v16, v16
    v_rcp_f32 v17, v17
    v_rcp_f32 v18, v18
    v_rcp_f32 v19, v19
    v_cmp_gt_u32 vcc, s65, v8
    v_fma_f32 v36, v20, v16, v36
    v_fma_f32 v37, v21, v17, v37
    v_fma_f32 v38, v22, v18, v38
    v_fma_f32 v39, v23, v19, v39
    v_max_f32 v36, 0, v36
    v_max_f32 v37, 0, v37
    v_max_f32 v38, 0, v38
    v_max_f32 v39, 0, v39
    v_add_f32 v36, v36, v28
    v_add_f32 v37, v37, v29
    v_add_f32 v38, v38, v30
    v_add_f32 v39, v39, v31
    v_cvt_pk_bf16_f32 v32, v36, v37
    v_cvt_pk_bf16_f32 v33, v38, v39
    s_and_saveexec_b64 s[96:97], vcc
    s_cbranch_execz K_exit
    buffer_store_dwordx2 v[32:33], v12, s[60:63], 0 offen
K_exit:
K_done:
    s_endpgm
.section .rodata,"a"
.p2align 6
.amdhsa_kernel standalone__edge_featured_mpnn_gatedgcn__graph_kernel
  .amdhsa_next_free_vgpr 128
  .amdhsa_next_free_sgpr 102
  .amdhsa_accum_offset 128
  .amdhsa_group_segment_fixed_size 0
  .amdhsa_kernarg_size 96
  .amdhsa_user_sgpr_count 2
  .amdhsa_user_sgpr_kernarg_segment_ptr 1
  .amdhsa_system_sgpr_workgroup_id_x 1
  .amdhsa_dx10_clamp 0
.end_amdhsa_kernel
```
